```python
import torch

def _softmax(x, axis=-1):
    return torch.softmax(x, dim=axis)
def _gelu(x):
    return torch.nn.functional.gelu(x, approximate="tanh")
def _silu(x):
    return torch.nn.functional.silu(x)
def _sigmoid(x):
    return torch.sigmoid(x)
def _layernorm(x, axis=-1, eps=1e-5):
    m = x.mean(dim=axis, keepdim=True)
    v = x.var(dim=axis, keepdim=True, unbiased=False)
    return (x - m) / torch.sqrt(v + eps)
def _scatter_add(tgt, idx, src, axis=0):
    return tgt.clone().index_add_(axis, idx, src)
def _segment_sum(src, seg, n):
    out = torch.zeros((n,) + src.shape[1:], dtype=src.dtype)
    return out.index_add_(0, seg, src)
def _pad(x, pw):
    flat = tuple(v for pair in reversed(pw) for v in pair)
    return torch.nn.functional.pad(x, flat)

kernel_name = 'gated_mix__sliding_block_cached__sliding_block_cached__decode'

def setup_inputs():

    _w = (lambda a: (lambda t: t.to(torch.bfloat16) if t.is_floating_point() else t)(torch.as_tensor(a)))
    def _A_setup():
        B, Sq, D = 4, 1, 512
        Hq, Hkv, Sk, Dh = 32, 8, 8192, 128
        assert Hq % Hkv == 0, (Hq, Hkv)
        return {
            "x": _w((lambda *s: torch.randn(*s, dtype=torch.bfloat16) * 0.05)(B, Sq, D)),
            "k_cache": _w((lambda *s: torch.randn(*s, dtype=torch.bfloat16) * 6.4)(B, Hkv, Sk, Dh)),
            "v_cache": _w((lambda *s: torch.randn(*s, dtype=torch.bfloat16) * 0.05)(B, Hkv, Sk, Dh)),
            "wq": _w((lambda *s: torch.randn(*s, dtype=torch.bfloat16) * 6.4)(D, Hq * Dh) * (D ** -0.5)),
            "wo": _w((lambda *s: torch.randn(*s, dtype=torch.bfloat16) * 0.05)(Hq * Dh, D) * ((Hq * Dh) ** -0.5)),
        }
    _A_in = _A_setup()

    def _B_setup():
        B, Sq, D = 4, 1, 512
        Hq, Hkv, Sk, Dh = 32, 8, 8192, 128
        assert Hq % Hkv == 0, (Hq, Hkv)
        return {
            "x": _w((lambda *s: torch.randn(*s, dtype=torch.bfloat16) * 0.05)(B, Sq, D)),
            "k_cache": _w((lambda *s: torch.randn(*s, dtype=torch.bfloat16) * 6.4)(B, Hkv, Sk, Dh)),
            "v_cache": _w((lambda *s: torch.randn(*s, dtype=torch.bfloat16) * 0.05)(B, Hkv, Sk, Dh)),
            "wq": _w((lambda *s: torch.randn(*s, dtype=torch.bfloat16) * 6.4)(D, Hq * Dh) * (D ** -0.5)),
            "wo": _w((lambda *s: torch.randn(*s, dtype=torch.bfloat16) * 0.05)(Hq * Dh, D) * ((Hq * Dh) ** -0.5)),
        }
    _B_in = _B_setup()

    return {
        "A_x": _A_in["x"],
        "A_k_cache": _A_in["k_cache"],
        "A_v_cache": _A_in["v_cache"],
        "A_wq": _A_in["wq"],
        "A_wo": _A_in["wo"],
        "B_x": _B_in["x"],
        "B_k_cache": _B_in["k_cache"],
        "B_v_cache": _B_in["v_cache"],
        "B_wq": _B_in["wq"],
        "B_wo": _B_in["wo"],
        "gate_w": _w((lambda *s: torch.randn(*s, dtype=torch.bfloat16) * 0.05)(512) * 16.0),
    }

def reference(A_x, A_k_cache, A_v_cache, A_wq, A_wo, B_x, B_k_cache, B_v_cache, B_wq, B_wo, gate_w):
    def _A_ref(x, k_cache, v_cache, wq, wo):
        B, Sq, D = x.shape
        Hq, Dh = 32, 128
        Hkv, Sk = k_cache.shape[1], k_cache.shape[2]
        W = min(4096, max(256, Sk // 4))
        rep = Hq // Hkv
        q = (lambda x, *d: x.permute(*d))((x @ wq).reshape(B, Sq, Hq, Dh), 0, 2, 1, 3)
        k = (lambda x, n, axis: torch.repeat_interleave(x, n, dim=axis))(k_cache[:, :, Sk - W:, :], rep, axis=1)
        v = (lambda x, n, axis: torch.repeat_interleave(x, n, dim=axis))(v_cache[:, :, Sk - W:, :], rep, axis=1)
        scores = torch.einsum("bhqd,bhkd->bhqk", q, k) * (Dh ** -0.5)
        p = _softmax(scores, axis=-1)
        o = torch.einsum("bhqk,bhkd->bhqd", p, v)
        return (lambda x, *d: x.permute(*d))(o, 0, 2, 1, 3).reshape(B, Sq, Hq * Dh) @ wo

    def _B_ref(x, k_cache, v_cache, wq, wo):
        B, Sq, D = x.shape
        Hq, Dh = 32, 128
        Hkv, Sk = k_cache.shape[1], k_cache.shape[2]
        W = min(4096, max(256, Sk // 4))
        rep = Hq // Hkv
        q = (lambda x, *d: x.permute(*d))((x @ wq).reshape(B, Sq, Hq, Dh), 0, 2, 1, 3)
        k = (lambda x, n, axis: torch.repeat_interleave(x, n, dim=axis))(k_cache[:, :, Sk - W:, :], rep, axis=1)
        v = (lambda x, n, axis: torch.repeat_interleave(x, n, dim=axis))(v_cache[:, :, Sk - W:, :], rep, axis=1)
        scores = torch.einsum("bhqd,bhkd->bhqk", q, k) * (Dh ** -0.5)
        p = _softmax(scores, axis=-1)
        o = torch.einsum("bhqk,bhkd->bhqd", p, v)
        return (lambda x, *d: x.permute(*d))(o, 0, 2, 1, 3).reshape(B, Sq, Hq * Dh) @ wo

    x = A_x
    g = _sigmoid((x * gate_w).sum(-1, keepdims=True))
    a = _A_ref(x, A_k_cache, A_v_cache, A_wq, A_wo)
    b = _B_ref(x, B_k_cache, B_v_cache, B_wq, B_wo)
    return g * a + (1 - g) * b
```

```asm
; @launch grid=(256,1,1) block=(768,1,1) lds=28672
.amdgcn_target "amdgcn-amd-amdhsa--gfx950"
.text
.globl gated_mix__sliding_block_cached__sliding_block_cached__decode_kernel
.p2align 12
.p2align 8
.type gated_mix__sliding_block_cached__sliding_block_cached__decode_kernel,@function
gated_mix__sliding_block_cached__sliding_block_cached__decode_kernel:
    s_bfe_u32 s29, s2, 0x10002
    s_mul_i32 s3, s29, 40
    s_cmp_ge_u32 s2, 256
    s_cbranch_scc1 L_end
    s_load_dwordx2 s[16:17], s[0:1], s3 offset:24
    s_load_dwordx2 s[24:25], s[0:1], 0
    s_load_dwordx2 s[4:5], s[0:1], s3 offset:8
    s_load_dwordx2 s[8:9], s[0:1], s3 offset:16
    s_load_dwordx2 s[12:13], s[0:1], 104
    v_lshrrev_b32 v1, 6, v0
    s_lshr_b32 s30, s2, 3
    v_readfirstlane_b32 s33, v1
    s_and_b32 s28, s2, 3
    s_lshl_b32 s28, s28, 1
    s_lshr_b32 s31, s30, 4
    s_or_b32 s28, s28, s31
    s_bfe_u32 s31, s30, 0x20002
    s_and_b32 s32, s30, 3
    v_and_b32 v0, 63, v0
    v_and_b32 v3, 15, v0
    v_lshrrev_b32 v4, 4, v0
    v_bfe_u32 v5, v0, 2, 2
    v_and_b32 v6, 3, v0
    s_cmp_ge_u32 s33, 4
    s_cbranch_scc1 L_S
    s_setprio 3
    s_getpc_b64 s[42:43]
    s_mul_i32 s3, s33, 2176
    v_lshl_add_u32 v12, v0, 7, s3
    s_mov_b64 exec, 0x1ffff
    v_min_u32 v12, L_last-L_pfbase, v12
L_pfbase:
    global_load_dword v108, v12, s[42:43]
    s_mov_b64 exec, -1
    s_mul_i32 s3, s29, 40
    s_mov_b32 s18, 0x400000
    s_mov_b32 s19, 0x20000
    s_mov_b32 s26, 4096
    s_mov_b32 s27, 0x20000
    v_lshlrev_b32 v1, 16, v4
    v_lshl_add_u32 v1, v3, 4, v1
    v_lshlrev_b32 v2, 10, v5
    v_lshl_add_u32 v2, v4, 4, v2
    v_lshl_add_u32 v2, v6, 2, v2
    s_lshl_b32 s44, s28, 2
    s_add_u32 s44, s44, s31
    s_lshl_b32 s39, s32, 2
    s_add_u32 s39, s39, s33
    s_lshl_b32 s35, s39, 18
    s_lshl_b32 s45, s44, 8
    s_add_u32 s35, s35, s45
    s_lshl_b32 s39, s39, 6
    s_waitcnt lgkmcnt(0)
    buffer_load_dword v104, v2, s[24:27], s39 offen
    buffer_load_dwordx4 v[8:11], v1, s[16:19], s35 offen nt
    s_add_u32 s35, s35, 8192
    buffer_load_dwordx4 v[12:15], v1, s[16:19], s35 offen nt
    s_add_u32 s35, s35, 8192
    buffer_load_dwordx4 v[16:19], v1, s[16:19], s35 offen nt
    s_add_u32 s35, s35, 8192
    v_mov_b32 v112, 0
    v_mov_b32 v113, 0
    v_mov_b32 v114, 0
    v_mov_b32 v115, 0
    ds_write_b128 v112, v[112:115] offset:1536
    ds_write_b128 v112, v[112:115] offset:1552
    s_waitcnt lgkmcnt(0)
    s_barrier
    s_branch L_C
L_S:
    s_setprio 1
    s_mov_b32 s6, 0x4000000
    s_mov_b32 s7, 0x20000
    s_mov_b32 s10, 0x4000000
    s_mov_b32 s11, 0x20000
    s_lshl_b32 s35, s31, 3
    s_add_u32 s35, s35, s28
    s_lshl_b32 s35, s35, 4
    s_add_u32 s35, s35, s32
    s_lshl_b32 s35, s35, 5
    s_add_u32 s35, s35, s33
    s_lshl_b32 s35, s35, 12
    s_add_u32 s35, s35, 1556480
    s_lshl_b32 s3, s32, 10
    s_add_u32 s35, s35, s3
    v_lshlrev_b32 v1, 8, v5
    v_lshl_add_u32 v1, v4, 6, v1
    v_lshl_add_u32 v1, v6, 4, v1
    v_mul_u32_u24 v2, 272, v6
    v_lshl_add_u32 v2, v4, 6, v2
    v_lshl_add_u32 v148, v5, 4, v2
    v_lshlrev_b32 v5, 4, v3
    v_lshl_add_u32 v5, v4, 8, v5
    s_barrier
    s_waitcnt lgkmcnt(0)
    buffer_load_dwordx4 v[8:11], v1, s[4:7], s35 offen nt
    s_load_dword s34, s[12:13], 0
    s_mov_b32 s14, 6291456
    s_mov_b32 s15, 0x20000
    s_mov_b32 s36, 0x05040100
    s_mov_b32 s37, 0x07060302
    v_mov_b32 v7, 0
    v_mov_b32 v151, 1
    v_lshlrev_b32 v6, 5, v6
    s_lshl_b32 s3, s33, 2
    s_sub_u32 s3, s3, 16
    v_add_u32 v3, s3, v6
    v_and_b32 v149, 3, v0
    v_mul_u32_u24 v149, 544, v149
    v_lshl_add_u32 v149, v4, 7, v149
    v_bfe_u32 v150, v0, 2, 2
    v_lshl_add_u32 v149, v150, 4, v149
    s_mul_i32 s3, s33, 2176
    s_add_u32 s3, s3, -6656
    v_add_u32 v149, s3, v149
    s_waitcnt vmcnt(0)
    s_xor_b32 s39, s35, 1024
    buffer_load_dwordx4 v[12:15], v1, s[4:7], s39 offen nt
    s_xor_b32 s39, s35, 2048
    buffer_load_dwordx4 v[16:19], v1, s[4:7], s39 offen nt
    s_waitcnt vmcnt(1)
    s_xor_b32 s39, s35, 3072
    buffer_load_dwordx4 v[20:23], v1, s[4:7], s39 offen nt
    s_waitcnt vmcnt(1)
    s_xor_b32 s39, s35, 32768
    buffer_load_dwordx4 v[24:27], v1, s[4:7], s39 offen nt
    s_xor_b32 s39, s35, 33792
    buffer_load_dwordx4 v[28:31], v1, s[4:7], s39 offen nt
    s_waitcnt vmcnt(2)
    s_xor_b32 s39, s35, 34816
    buffer_load_dwordx4 v[32:35], v1, s[4:7], s39 offen nt
    s_waitcnt vmcnt(2)
    s_xor_b32 s39, s35, 35840
    buffer_load_dwordx4 v[36:39], v1, s[4:7], s39 offen nt
    s_waitcnt vmcnt(2)
    s_xor_b32 s39, s35, 65536
    buffer_load_dwordx4 v[40:43], v1, s[4:7], s39 offen nt
    s_waitcnt vmcnt(2)
    s_xor_b32 s39, s35, 66560
    buffer_load_dwordx4 v[44:47], v1, s[4:7], s39 offen nt
    s_waitcnt vmcnt(2)
    s_xor_b32 s39, s35, 67584
    buffer_load_dwordx4 v[48:51], v1, s[4:7], s39 offen nt
    s_waitcnt vmcnt(2)
    s_xor_b32 s39, s35, 68608
    buffer_load_dwordx4 v[52:55], v1, s[4:7], s39 offen nt
    s_waitcnt vmcnt(2)
    s_xor_b32 s39, s35, 98304
    buffer_load_dwordx4 v[56:59], v1, s[4:7], s39 offen nt
    s_waitcnt vmcnt(2)
    s_xor_b32 s39, s35, 99328
    buffer_load_dwordx4 v[60:63], v1, s[4:7], s39 offen nt
    s_waitcnt vmcnt(2)
    s_xor_b32 s39, s35, 100352
    buffer_load_dwordx4 v[64:67], v1, s[4:7], s39 offen nt
    s_waitcnt vmcnt(2)
    s_xor_b32 s39, s35, 101376
    buffer_load_dwordx4 v[68:71], v1, s[4:7], s39 offen nt
    s_waitcnt vmcnt(2)
    buffer_load_dwordx4 v[72:75], v5, s[8:11], s35 offen nt
    s_waitcnt vmcnt(2)
    s_xor_b32 s39, s35, 1024
    buffer_load_dwordx4 v[76:79], v5, s[8:11], s39 offen nt
    s_waitcnt vmcnt(2)
    s_xor_b32 s39, s35, 2048
    buffer_load_dwordx4 v[80:83], v5, s[8:11], s39 offen nt
    s_waitcnt vmcnt(3)
    s_mov_b32 s38, 1048576
    s_branch L_spl_q
L_sp_q:
    s_sleep 4
L_spl_q:
    ds_read_b32 v2, v7 offset:1540
    ds_read_b128 v[136:139], v148 offset:0
    s_sub_u32 s38, s38, 1
    s_cselect_b32 s3, 0, -1
    s_waitcnt lgkmcnt(0)
    v_readfirstlane_b32 s40, v2
    s_orn2_b32 s40, s40, s3
    s_cmp_lt_u32 s40, 4
    s_cbranch_scc1 L_sp_q
    v_mfma_f32_16x16x32_bf16 v[140:143], v[8:11], v[136:139], 0
    v_mfma_f32_16x16x32_bf16 v[144:147], v[12:15], v[136:139], 0
    v_mfma_f32_16x16x32_bf16 v[8:11], v[16:19], v[136:139], 0
    v_mfma_f32_16x16x32_bf16 v[12:15], v[20:23], v[136:139], 0
    v_mfma_f32_16x16x32_bf16 v[16:19], v[24:27], v[136:139], 0
    v_mfma_f32_16x16x32_bf16 v[20:23], v[28:31], v[136:139], 0
    v_mfma_f32_16x16x32_bf16 v[24:27], v[32:35], v[136:139], 0
    v_mfma_f32_16x16x32_bf16 v[28:31], v[36:39], v[136:139], 0
    v_mfma_f32_16x16x32_bf16 v[32:35], v[40:43], v[136:139], 0
    v_mfma_f32_16x16x32_bf16 v[36:39], v[44:47], v[136:139], 0
    v_mfma_f32_16x16x32_bf16 v[40:43], v[48:51], v[136:139], 0
    v_mfma_f32_16x16x32_bf16 v[44:47], v[52:55], v[136:139], 0
    v_mfma_f32_16x16x32_bf16 v[48:51], v[56:59], v[136:139], 0
    v_mfma_f32_16x16x32_bf16 v[52:55], v[60:63], v[136:139], 0
    v_mfma_f32_16x16x32_bf16 v[56:59], v[64:67], v[136:139], 0
    v_mfma_f32_16x16x32_bf16 v[60:63], v[68:71], v[136:139], 0
    s_mov_b32 s40, 1035273459
    s_mov_b32 s41, 1069066811
    s_mul_i32 s34, s34, 1664525
    s_add_u32 s34, s34, 1013904223
    s_waitcnt vmcnt(2)
    s_xor_b32 s39, s35, 3072
    buffer_load_dwordx4 v[84:87], v5, s[8:11], s39 offen nt
    v_add_f32_dpp v152, v141, v140 row_ror:12 row_mask:0xf bank_mask:0xf
    v_add_f32_dpp v153, v145, v144 row_ror:12 row_mask:0xf bank_mask:0xf
    v_add_f32_dpp v154, v9, v8 row_ror:12 row_mask:0xf bank_mask:0xf
    v_add_f32_dpp v155, v13, v12 row_ror:12 row_mask:0xf bank_mask:0xf
    v_add_f32_dpp v156, v17, v16 row_ror:12 row_mask:0xf bank_mask:0xf
    v_add_f32_dpp v157, v21, v20 row_ror:12 row_mask:0xf bank_mask:0xf
    v_add_f32_dpp v158, v25, v24 row_ror:12 row_mask:0xf bank_mask:0xf
    v_add_f32_dpp v159, v29, v28 row_ror:12 row_mask:0xf bank_mask:0xf
    v_add_f32_dpp v160, v33, v32 row_ror:12 row_mask:0xf bank_mask:0xf
    v_add_f32_dpp v161, v37, v36 row_ror:12 row_mask:0xf bank_mask:0xf
    v_add_f32_dpp v162, v41, v40 row_ror:12 row_mask:0xf bank_mask:0xf
    v_add_f32_dpp v163, v45, v44 row_ror:12 row_mask:0xf bank_mask:0xf
    v_add_f32_dpp v164, v49, v48 row_ror:12 row_mask:0xf bank_mask:0xf
    v_add_f32_dpp v165, v53, v52 row_ror:12 row_mask:0xf bank_mask:0xf
    v_add_f32_dpp v166, v57, v56 row_ror:12 row_mask:0xf bank_mask:0xf
    v_add_f32_dpp v167, v61, v60 row_ror:12 row_mask:0xf bank_mask:0xf
    v_add_f32_dpp v152, v142, v152 row_ror:8 row_mask:0xf bank_mask:0xf
    v_add_f32_dpp v153, v146, v153 row_ror:8 row_mask:0xf bank_mask:0xf
    v_add_f32_dpp v154, v10, v154 row_ror:8 row_mask:0xf bank_mask:0xf
    v_add_f32_dpp v155, v14, v155 row_ror:8 row_mask:0xf bank_mask:0xf
    v_add_f32_dpp v156, v18, v156 row_ror:8 row_mask:0xf bank_mask:0xf
    v_add_f32_dpp v157, v22, v157 row_ror:8 row_mask:0xf bank_mask:0xf
    v_add_f32_dpp v158, v26, v158 row_ror:8 row_mask:0xf bank_mask:0xf
    v_add_f32_dpp v159, v30, v159 row_ror:8 row_mask:0xf bank_mask:0xf
    v_add_f32_dpp v160, v34, v160 row_ror:8 row_mask:0xf bank_mask:0xf
    v_add_f32_dpp v161, v38, v161 row_ror:8 row_mask:0xf bank_mask:0xf
    v_add_f32_dpp v162, v42, v162 row_ror:8 row_mask:0xf bank_mask:0xf
    v_add_f32_dpp v163, v46, v163 row_ror:8 row_mask:0xf bank_mask:0xf
    v_add_f32_dpp v164, v50, v164 row_ror:8 row_mask:0xf bank_mask:0xf
    v_add_f32_dpp v165, v54, v165 row_ror:8 row_mask:0xf bank_mask:0xf
    v_add_f32_dpp v166, v58, v166 row_ror:8 row_mask:0xf bank_mask:0xf
    v_add_f32_dpp v167, v62, v167 row_ror:8 row_mask:0xf bank_mask:0xf
    v_add_f32_dpp v152, v143, v152 row_ror:4 row_mask:0xf bank_mask:0xf
    v_add_f32_dpp v153, v147, v153 row_ror:4 row_mask:0xf bank_mask:0xf
    v_add_f32_dpp v154, v11, v154 row_ror:4 row_mask:0xf bank_mask:0xf
    v_add_f32_dpp v155, v15, v155 row_ror:4 row_mask:0xf bank_mask:0xf
    v_add_f32_dpp v156, v19, v156 row_ror:4 row_mask:0xf bank_mask:0xf
    v_add_f32_dpp v157, v23, v157 row_ror:4 row_mask:0xf bank_mask:0xf
    v_add_f32_dpp v158, v27, v158 row_ror:4 row_mask:0xf bank_mask:0xf
    v_add_f32_dpp v159, v31, v159 row_ror:4 row_mask:0xf bank_mask:0xf
    v_add_f32_dpp v160, v35, v160 row_ror:4 row_mask:0xf bank_mask:0xf
    v_add_f32_dpp v161, v39, v161 row_ror:4 row_mask:0xf bank_mask:0xf
    v_add_f32_dpp v162, v43, v162 row_ror:4 row_mask:0xf bank_mask:0xf
    v_add_f32_dpp v163, v47, v163 row_ror:4 row_mask:0xf bank_mask:0xf
    v_add_f32_dpp v164, v51, v164 row_ror:4 row_mask:0xf bank_mask:0xf
    v_add_f32_dpp v165, v55, v165 row_ror:4 row_mask:0xf bank_mask:0xf
    v_add_f32_dpp v166, v59, v166 row_ror:4 row_mask:0xf bank_mask:0xf
    v_add_f32_dpp v167, v63, v167 row_ror:4 row_mask:0xf bank_mask:0xf
    v_cvt_pk_bf16_f32 v136, v152, v153
    v_cvt_pk_bf16_f32 v137, v154, v155
    v_cvt_pk_bf16_f32 v138, v156, v157
    v_cvt_pk_bf16_f32 v139, v158, v159
    v_cvt_pk_bf16_f32 v140, v160, v161
    v_cvt_pk_bf16_f32 v141, v162, v163
    v_cvt_pk_bf16_f32 v142, v164, v165
    v_cvt_pk_bf16_f32 v143, v166, v167
    v_lshlrev_b32 v152, 16, v136
    v_and_b32 v153, 0xffff0000, v136
    v_lshlrev_b32 v154, 16, v137
    v_and_b32 v155, 0xffff0000, v137
    v_lshlrev_b32 v156, 16, v138
    v_and_b32 v157, 0xffff0000, v138
    v_lshlrev_b32 v158, 16, v139
    v_and_b32 v159, 0xffff0000, v139
    v_lshlrev_b32 v160, 16, v140
    v_and_b32 v161, 0xffff0000, v140
    v_lshlrev_b32 v162, 16, v141
    v_and_b32 v163, 0xffff0000, v141
    v_lshlrev_b32 v164, 16, v142
    v_and_b32 v165, 0xffff0000, v142
    v_lshlrev_b32 v166, 16, v143
    v_and_b32 v167, 0xffff0000, v143
    s_waitcnt vmcnt(2)
    s_xor_b32 s39, s35, 32768
    buffer_load_dwordx4 v[88:91], v5, s[8:11], s39 offen nt
    v_pk_mul_f32 v[152:153], v[152:153], s[40:41] op_sel_hi:[1,0]
    v_pk_mul_f32 v[154:155], v[154:155], s[40:41] op_sel_hi:[1,0]
    v_pk_mul_f32 v[156:157], v[156:157], s[40:41] op_sel_hi:[1,0]
    v_pk_mul_f32 v[158:159], v[158:159], s[40:41] op_sel_hi:[1,0]
    v_pk_mul_f32 v[160:161], v[160:161], s[40:41] op_sel_hi:[1,0]
    v_pk_mul_f32 v[162:163], v[162:163], s[40:41] op_sel_hi:[1,0]
    v_pk_mul_f32 v[164:165], v[164:165], s[40:41] op_sel_hi:[1,0]
    v_pk_mul_f32 v[166:167], v[166:167], s[40:41] op_sel_hi:[1,0]
    v_cvt_pk_bf16_f32 v136, v152, v153
    v_cvt_pk_bf16_f32 v137, v154, v155
    v_cvt_pk_bf16_f32 v138, v156, v157
    v_cvt_pk_bf16_f32 v139, v158, v159
    v_cvt_pk_bf16_f32 v140, v160, v161
    v_cvt_pk_bf16_f32 v141, v162, v163
    v_cvt_pk_bf16_f32 v142, v164, v165
    v_cvt_pk_bf16_f32 v143, v166, v167
    v_lshlrev_b32 v152, 16, v136
    v_and_b32 v153, 0xffff0000, v136
    v_lshlrev_b32 v154, 16, v137
    v_and_b32 v155, 0xffff0000, v137
    v_lshlrev_b32 v156, 16, v138
    v_and_b32 v157, 0xffff0000, v138
    v_lshlrev_b32 v158, 16, v139
    v_and_b32 v159, 0xffff0000, v139
    v_lshlrev_b32 v160, 16, v140
    v_and_b32 v161, 0xffff0000, v140
    v_lshlrev_b32 v162, 16, v141
    v_and_b32 v163, 0xffff0000, v141
    v_lshlrev_b32 v164, 16, v142
    v_and_b32 v165, 0xffff0000, v142
    v_lshlrev_b32 v166, 16, v143
    v_and_b32 v167, 0xffff0000, v143
    v_max3_f32 v1, v152, v153, v154
    v_max3_f32 v2, v155, v156, v157
    v_max3_f32 v1, v1, v158, v159
    v_max3_f32 v2, v2, v160, v161
    v_max3_f32 v1, v1, v162, v163
    v_max3_f32 v2, v2, v164, v165
    v_max3_f32 v1, v1, v166, v167
    v_max_f32 v1, v1, v2
    v_mov_b32 v2, v1
    s_nop 1
    v_permlane32_swap_b32 v1, v2
    v_max_f32 v1, v1, v2
    v_mov_b32 v2, v1
    s_nop 1
    v_permlane16_swap_b32 v1, v2
    v_max_f32 v1, v1, v2
    v_mul_f32 v1, s41, v1
    s_mov_b64 exec, 15
    ds_write_b32 v3, v1 offset:1280
    s_mov_b64 exec, 1
    ds_add_u32 v7, v151 offset:1544
    s_mov_b64 exec, -1
    s_waitcnt vmcnt(2)
    s_xor_b32 s39, s35, 33792
    buffer_load_dwordx4 v[92:95], v5, s[8:11], s39 offen nt
    s_mov_b32 s38, 1048576
    s_branch L_spl_m
L_sp_m:
    s_sleep 2
L_spl_m:
    ds_read_b32 v2, v7 offset:1544
    ds_read_b128 v[136:139], v6 offset:1280
    ds_read_b128 v[140:143], v6 offset:1296
    s_sub_u32 s38, s38, 1
    s_cselect_b32 s3, 0, -1
    s_waitcnt lgkmcnt(0)
    v_readfirstlane_b32 s40, v2
    s_orn2_b32 s40, s40, s3
    s_cmp_lt_u32 s40, 8
    s_cbranch_scc1 L_sp_m
    v_max3_f32 v136, v136, v137, v138
    v_max3_f32 v139, v139, v140, v141
    v_max3_f32 v136, v136, v142, v143
    v_max_f32 v1, v136, v139
    v_fma_f32 v152, v152, s41, -v1
    v_fma_f32 v153, v153, s41, -v1
    v_fma_f32 v154, v154, s41, -v1
    v_fma_f32 v155, v155, s41, -v1
    v_fma_f32 v156, v156, s41, -v1
    v_fma_f32 v157, v157, s41, -v1
    v_fma_f32 v158, v158, s41, -v1
    v_fma_f32 v159, v159, s41, -v1
    v_fma_f32 v160, v160, s41, -v1
    v_fma_f32 v161, v161, s41, -v1
    v_fma_f32 v162, v162, s41, -v1
    v_fma_f32 v163, v163, s41, -v1
    v_fma_f32 v164, v164, s41, -v1
    v_fma_f32 v165, v165, s41, -v1
    v_fma_f32 v166, v166, s41, -v1
    v_fma_f32 v167, v167, s41, -v1
    v_exp_f32 v152, v152
    v_exp_f32 v153, v153
    v_exp_f32 v154, v154
    v_exp_f32 v155, v155
    v_exp_f32 v156, v156
    v_exp_f32 v157, v157
    v_exp_f32 v158, v158
    v_exp_f32 v159, v159
    v_exp_f32 v160, v160
    v_exp_f32 v161, v161
    v_exp_f32 v162, v162
    v_exp_f32 v163, v163
    v_exp_f32 v164, v164
    v_exp_f32 v165, v165
    v_exp_f32 v166, v166
    v_exp_f32 v167, v167
    s_waitcnt vmcnt(2)
    s_xor_b32 s39, s35, 34816
    buffer_load_dwordx4 v[96:99], v5, s[8:11], s39 offen nt
    v_cvt_pk_bf16_f32 v136, v152, v153
    v_cvt_pk_bf16_f32 v137, v154, v155
    v_cvt_pk_bf16_f32 v138, v156, v157
    v_cvt_pk_bf16_f32 v139, v158, v159
    v_cvt_pk_bf16_f32 v140, v160, v161
    v_cvt_pk_bf16_f32 v141, v162, v163
    v_cvt_pk_bf16_f32 v142, v164, v165
    v_cvt_pk_bf16_f32 v143, v166, v167
    v_pk_add_f32 v[152:153], v[152:153], v[160:161]
    v_pk_add_f32 v[154:155], v[154:155], v[162:163]
    v_pk_add_f32 v[156:157], v[156:157], v[164:165]
    v_pk_add_f32 v[158:159], v[158:159], v[166:167]
    v_pk_add_f32 v[152:153], v[152:153], v[156:157]
    v_pk_add_f32 v[154:155], v[154:155], v[158:159]
    v_pk_add_f32 v[152:153], v[152:153], v[154:155]
    v_add_f32 v160, v152, v153
    v_mov_b32 v152, v160
    s_nop 1
    v_permlane32_swap_b32 v160, v152
    v_add_f32 v160, v160, v152
    v_mov_b32 v152, v160
    s_nop 1
    v_permlane16_swap_b32 v160, v152
    v_add_f32 v160, v160, v152
    s_mov_b64 exec, 15
    ds_write_b32 v3, v160 offset:1408
    s_mov_b64 exec, 1
    ds_add_u32 v7, v151 offset:1556
    s_mov_b64 exec, -1
    v_cmp_eq_u32 vcc, 0, v150
    v_cndmask_b32 v32, 0, -1, vcc
    v_cmp_eq_u32 vcc, 1, v150
    v_cndmask_b32 v33, 0, -1, vcc
    v_cmp_eq_u32 vcc, 2, v150
    v_cndmask_b32 v34, 0, -1, vcc
    v_cmp_eq_u32 vcc, 3, v150
    v_cndmask_b32 v35, 0, -1, vcc
    s_waitcnt vmcnt(2)
    s_xor_b32 s39, s35, 35840
    buffer_load_dwordx4 v[100:103], v5, s[8:11], s39 offen nt
    v_and_b32 v16, v136, v32
    v_and_b32 v17, v137, v32
    v_and_b32 v18, v138, v32
    v_and_b32 v19, v139, v32
    v_and_b32_dpp v20, v136, v33 row_ror:4 row_mask:0xf bank_mask:0xf
    v_and_b32_dpp v21, v137, v33 row_ror:4 row_mask:0xf bank_mask:0xf
    v_and_b32_dpp v22, v138, v33 row_ror:4 row_mask:0xf bank_mask:0xf
    v_and_b32_dpp v23, v139, v33 row_ror:4 row_mask:0xf bank_mask:0xf
    v_and_b32_dpp v24, v136, v34 row_ror:8 row_mask:0xf bank_mask:0xf
    v_and_b32_dpp v25, v137, v34 row_ror:8 row_mask:0xf bank_mask:0xf
    v_and_b32_dpp v26, v138, v34 row_ror:8 row_mask:0xf bank_mask:0xf
    v_and_b32_dpp v27, v139, v34 row_ror:8 row_mask:0xf bank_mask:0xf
    v_and_b32_dpp v28, v136, v35 row_ror:12 row_mask:0xf bank_mask:0xf
    v_and_b32_dpp v29, v137, v35 row_ror:12 row_mask:0xf bank_mask:0xf
    v_and_b32_dpp v30, v138, v35 row_ror:12 row_mask:0xf bank_mask:0xf
    v_and_b32_dpp v31, v139, v35 row_ror:12 row_mask:0xf bank_mask:0xf
    s_waitcnt vmcnt(2)
    s_xor_b32 s39, s35, 65536
    buffer_load_dwordx4 v[104:107], v5, s[8:11], s39 offen nt
    s_waitcnt vmcnt(2)
    s_xor_b32 s39, s35, 66560
    buffer_load_dwordx4 v[108:111], v5, s[8:11], s39 offen nt
    s_waitcnt vmcnt(2)
    s_xor_b32 s39, s35, 67584
    buffer_load_dwordx4 v[112:115], v5, s[8:11], s39 offen nt
    s_waitcnt vmcnt(3)
    v_perm_b32 v40, v76, v72, s36
    v_perm_b32 v44, v76, v72, s37
    v_perm_b32 v48, v77, v73, s36
    v_perm_b32 v52, v77, v73, s37
    v_perm_b32 v56, v78, v74, s36
    v_perm_b32 v60, v78, v74, s37
    v_perm_b32 v64, v79, v75, s36
    v_perm_b32 v68, v79, v75, s37
    v_perm_b32 v41, v84, v80, s36
    v_perm_b32 v45, v84, v80, s37
    v_perm_b32 v49, v85, v81, s36
    v_perm_b32 v53, v85, v81, s37
    v_perm_b32 v57, v86, v82, s36
    v_perm_b32 v61, v86, v82, s37
    v_perm_b32 v65, v87, v83, s36
    v_perm_b32 v69, v87, v83, s37
    s_waitcnt vmcnt(2)
    s_xor_b32 s39, s35, 68608
    buffer_load_dwordx4 v[116:119], v5, s[8:11], s39 offen nt
    v_perm_b32 v42, v92, v88, s36
    v_perm_b32 v46, v92, v88, s37
    v_perm_b32 v50, v93, v89, s36
    v_perm_b32 v54, v93, v89, s37
    v_perm_b32 v58, v94, v90, s36
    v_perm_b32 v62, v94, v90, s37
    v_perm_b32 v66, v95, v91, s36
    v_perm_b32 v70, v95, v91, s37
    v_perm_b32 v43, v100, v96, s36
    v_perm_b32 v47, v100, v96, s37
    v_perm_b32 v51, v101, v97, s36
    v_perm_b32 v55, v101, v97, s37
    v_perm_b32 v59, v102, v98, s36
    v_perm_b32 v63, v102, v98, s37
    v_perm_b32 v67, v103, v99, s36
    v_perm_b32 v71, v103, v99, s37
    v_mfma_f32_16x16x32_bf16 v[8:11], v[40:43], v[16:19], 0
    v_mfma_f32_16x16x32_bf16 v[12:15], v[56:59], v[16:19], 0
    v_mfma_f32_16x16x32_bf16 v[8:11], v[44:47], v[20:23], v[8:11]
    v_mfma_f32_16x16x32_bf16 v[12:15], v[60:63], v[20:23], v[12:15]
    v_mfma_f32_16x16x32_bf16 v[8:11], v[48:51], v[24:27], v[8:11]
    v_mfma_f32_16x16x32_bf16 v[12:15], v[64:67], v[24:27], v[12:15]
    v_mfma_f32_16x16x32_bf16 v[8:11], v[52:55], v[28:31], v[8:11]
    v_mfma_f32_16x16x32_bf16 v[12:15], v[68:71], v[28:31], v[12:15]
    s_waitcnt vmcnt(2)
    s_xor_b32 s39, s35, 98304
    buffer_load_dwordx4 v[120:123], v5, s[8:11], s39 offen nt
    s_waitcnt vmcnt(3)
    v_perm_b32 v72, v108, v104, s36
    v_perm_b32 v76, v108, v104, s37
    v_perm_b32 v80, v109, v105, s36
    v_perm_b32 v84, v109, v105, s37
    v_perm_b32 v88, v110, v106, s36
    v_perm_b32 v92, v110, v106, s37
    v_perm_b32 v96, v111, v107, s36
    v_perm_b32 v100, v111, v107, s37
    v_and_b32 v40, v140, v32
    v_and_b32 v41, v141, v32
    v_and_b32 v42, v142, v32
    v_and_b32 v43, v143, v32
    v_and_b32_dpp v44, v140, v33 row_ror:4 row_mask:0xf bank_mask:0xf
    v_and_b32_dpp v45, v141, v33 row_ror:4 row_mask:0xf bank_mask:0xf
    v_and_b32_dpp v46, v142, v33 row_ror:4 row_mask:0xf bank_mask:0xf
    v_and_b32_dpp v47, v143, v33 row_ror:4 row_mask:0xf bank_mask:0xf
    v_and_b32_dpp v48, v140, v34 row_ror:8 row_mask:0xf bank_mask:0xf
    v_and_b32_dpp v49, v141, v34 row_ror:8 row_mask:0xf bank_mask:0xf
    v_and_b32_dpp v50, v142, v34 row_ror:8 row_mask:0xf bank_mask:0xf
    v_and_b32_dpp v51, v143, v34 row_ror:8 row_mask:0xf bank_mask:0xf
    v_and_b32_dpp v52, v140, v35 row_ror:12 row_mask:0xf bank_mask:0xf
    v_and_b32_dpp v53, v141, v35 row_ror:12 row_mask:0xf bank_mask:0xf
    v_and_b32_dpp v54, v142, v35 row_ror:12 row_mask:0xf bank_mask:0xf
    v_and_b32_dpp v55, v143, v35 row_ror:12 row_mask:0xf bank_mask:0xf
    s_cmp_ge_u32 s33, 8
    s_cbranch_scc1 L_S_nr
    s_mul_i32 s3, s33, 544
    s_add_u32 s3, s3, -128
    v_lshl_add_u32 v161, v0, 3, s3
    s_lshl_b32 s3, s33, 5
    s_sub_u32 s3, s3, 128
    v_mov_b32 v162, s3
    s_lshl_b32 s3, s29, 3
    s_add_u32 s3, s3, s28
    s_lshl_b32 s3, s3, 2
    s_add_u32 s3, s3, s33
    s_sub_u32 s3, s3, 4
    s_lshl_b32 s3, s3, 2
    s_add_u32 s3, s3, s32
    s_lshl_b32 s3, s3, 2
    s_add_u32 s3, s3, s31
    s_lshl_b32 s46, s3, 9
    s_add_u32 s46, s46, 1048576
    v_lshlrev_b32 v163, 3, v0
    v_mov_b32 v165, s34
    s_mov_b32 s38, 1048576
    s_branch L_spl_l
L_sp_l:
    s_sleep 2
L_spl_l:
    ds_read_b32 v2, v7 offset:1556
    ds_read_b128 v[152:155], v162 offset:1408
    ds_read_b128 v[156:159], v162 offset:1424
    ds_read_b32 v1, v7 offset:1548
    s_sub_u32 s38, s38, 1
    s_cselect_b32 s3, 0, -1
    s_waitcnt lgkmcnt(0)
    v_readfirstlane_b32 s40, v2
    s_orn2_b32 s40, s40, s3
    s_cmp_lt_u32 s40, 8
    s_cbranch_scc1 L_sp_l
    v_readfirstlane_b32 s45, v1
    v_pk_add_f32 v[152:153], v[152:153], v[156:157]
    v_pk_add_f32 v[154:155], v[154:155], v[158:159]
    v_pk_add_f32 v[152:153], v[152:153], v[154:155]
    v_add_f32 v166, v152, v153
    v_rcp_f32 v166, v166
L_S_nr:
    s_waitcnt vmcnt(2)
    s_xor_b32 s39, s35, 99328
    buffer_load_dwordx4 v[124:127], v5, s[8:11], s39 offen nt
    s_waitcnt vmcnt(2)
    s_xor_b32 s39, s35, 100352
    buffer_load_dwordx4 v[128:131], v5, s[8:11], s39 offen nt
    s_waitcnt vmcnt(3)
    v_perm_b32 v73, v116, v112, s36
    v_perm_b32 v77, v116, v112, s37
    v_perm_b32 v81, v117, v113, s36
    v_perm_b32 v85, v117, v113, s37
    v_perm_b32 v89, v118, v114, s36
    v_perm_b32 v93, v118, v114, s37
    v_perm_b32 v97, v119, v115, s36
    v_perm_b32 v101, v119, v115, s37
    s_waitcnt vmcnt(2)
    s_xor_b32 s39, s35, 101376
    buffer_load_dwordx4 v[132:135], v5, s[8:11], s39 offen nt
    s_mov_b64 exec, 1
    ds_add_u32 v7, v151 offset:1560
    s_mov_b64 exec, -1
    s_waitcnt vmcnt(2)
    s_setprio 3
    v_perm_b32 v74, v124, v120, s36
    v_perm_b32 v78, v124, v120, s37
    v_perm_b32 v82, v125, v121, s36
    v_perm_b32 v86, v125, v121, s37
    v_perm_b32 v90, v126, v122, s36
    v_perm_b32 v94, v126, v122, s37
    v_perm_b32 v98, v127, v123, s36
    v_perm_b32 v102, v127, v123, s37
    s_waitcnt vmcnt(0)
    v_perm_b32 v75, v132, v128, s36
    v_perm_b32 v91, v134, v130, s36
    v_perm_b32 v79, v132, v128, s37
    v_mfma_f32_16x16x32_bf16 v[8:11], v[72:75], v[40:43], v[8:11]
    v_perm_b32 v95, v134, v130, s37
    v_mfma_f32_16x16x32_bf16 v[12:15], v[88:91], v[40:43], v[12:15]
    v_perm_b32 v83, v133, v129, s36
    v_mfma_f32_16x16x32_bf16 v[8:11], v[76:79], v[44:47], v[8:11]
    v_perm_b32 v99, v135, v131, s36
    v_mfma_f32_16x16x32_bf16 v[12:15], v[92:95], v[44:47], v[12:15]
    v_perm_b32 v87, v133, v129, s37
    v_mfma_f32_16x16x32_bf16 v[8:11], v[80:83], v[48:51], v[8:11]
    v_perm_b32 v103, v135, v131, s37
    v_mfma_f32_16x16x32_bf16 v[12:15], v[96:99], v[48:51], v[12:15]
    v_mfma_f32_16x16x32_bf16 v[8:11], v[84:87], v[52:55], v[8:11]
    v_mfma_f32_16x16x32_bf16 v[12:15], v[100:103], v[52:55], v[12:15]
    s_cmp_ge_u32 s33, 8
    s_nop 6
    ds_write_b128 v149, v[8:11]
    ds_write_b128 v149, v[12:15] offset:64
    s_waitcnt lgkmcnt(0)
    s_barrier
    s_cbranch_scc1 L_S_x
    ds_read_b64 v[8:9], v161 offset:0
    ds_read_b64 v[10:11], v161 offset:2176
    ds_read_b64 v[12:13], v161 offset:4352
    ds_read_b64 v[14:15], v161 offset:6528
    ds_read_b64 v[16:17], v161 offset:8704
    ds_read_b64 v[18:19], v161 offset:10880
    ds_read_b64 v[20:21], v161 offset:13056
    ds_read_b64 v[22:23], v161 offset:15232
    s_cmp_lg_u32 s45, 0
    s_waitcnt lgkmcnt(4)
    v_pk_add_f32 v[8:9], v[8:9], v[10:11]
    v_pk_add_f32 v[12:13], v[12:13], v[14:15]
    s_waitcnt lgkmcnt(2)
    v_pk_add_f32 v[16:17], v[16:17], v[18:19]
    v_pk_add_f32 v[8:9], v[8:9], v[12:13]
    s_waitcnt lgkmcnt(0)
    v_pk_add_f32 v[20:21], v[20:21], v[22:23]
    v_pk_add_f32 v[8:9], v[8:9], v[16:17]
    v_pk_add_f32 v[8:9], v[8:9], v[20:21]
    v_pk_mul_f32 v[8:9], v[8:9], v[166:167] op_sel_hi:[1,0]
    v_cvt_pk_bf16_f32 v164, v8, v9
    s_cbranch_scc1 L_S_y2
    buffer_store_dwordx2 v[164:165], v163, s[12:15], s46 offen
L_S_x:
    s_endpgm
L_C:
    s_load_dword s34, s[12:13], 0
    s_load_dwordx2 s[20:21], s[0:1], s3 offset:32
    s_load_dwordx2 s[52:53], s[0:1], 80
    s_load_dwordx2 s[56:57], s[0:1], 88
    s_mov_b32 s14, 6291456
    s_mov_b32 s15, 0x20000
    s_mov_b32 s22, 0x400000
    s_mov_b32 s23, 0x20000
    s_mov_b32 s36, 0x05040100
    s_mov_b32 s37, 0x07060302
    s_mov_b32 s54, 1024
    s_mov_b32 s55, 0x20000
    s_mov_b32 s58, 4096
    s_mov_b32 s59, 0x20000
    s_lshl_b32 s45, s29, 1
    s_lshr_b32 s3, s28, 2
    s_add_u32 s45, s45, s3
    v_lshlrev_b32 v109, 4, v0
    s_lshl_b32 s3, s29, 5
    s_add_u32 s47, s44, s3
    v_mov_b32 v110, 0
    v_mov_b32 v111, 1
    v_mov_b32 v133, 1024
    v_lshlrev_b32 v127, 3, v0
    v_mul_u32_u24 v122, 144, v4
    v_mul_u32_u24 v7, 576, v5
    v_add_u32 v7, v7, v122
    v_lshl_add_u32 v7, v6, 4, v7
    s_mul_i32 s3, s33, 2304
    s_add_u32 s3, s3, 19456
    v_add_u32 v7, s3, v7
    v_lshl_add_u32 v122, v6, 5, v122
    v_lshl_add_u32 v122, v5, 2, v122
    s_mul_i32 s3, s33, 576
    s_add_u32 s3, s3, 19456
    v_add_u32 v122, s3, v122
    v_add_u32 v123, 2304, v122
    v_add_u32 v124, 4608, v122
    v_add_u32 v125, 6912, v122
    v_cmp_eq_u32 vcc, 0, v6
    v_cndmask_b32 v96, 0, -1, vcc
    v_cmp_eq_u32 vcc, 1, v6
    v_cndmask_b32 v97, 0, -1, vcc
    v_cmp_eq_u32 vcc, 2, v6
    v_cndmask_b32 v98, 0, -1, vcc
    v_cmp_eq_u32 vcc, 3, v6
    v_cndmask_b32 v99, 0, -1, vcc
    s_lshl_b32 s46, s47, 2
    s_add_u32 s46, s46, s32
    s_lshl_b32 s46, s46, 2
    s_add_u32 s46, s46, s33
    s_lshl_b32 s46, s46, 9
    s_add_u32 s46, s46, 1048576
    s_lshl_b32 s4, s29, 3
    s_add_u32 s4, s4, s28
    s_lshl_b32 s4, s4, 2
    s_add_u32 s4, s4, s33
    s_lshl_b32 s4, s4, 2
    s_add_u32 s4, s4, s31
    s_lshl_b32 s4, s4, 2
    s_add_u32 s4, s4, s32
    s_lshl_b32 s4, s4, 3
    s_add_u32 s4, s4, 786432
    s_sub_u32 s3, s32, s31
    s_add_u32 s44, s44, s3
    s_add_u32 s47, s47, s3
    s_add_u32 s32, s31, 2
    s_and_b32 s32, s32, 3
    s_mov_b32 s41, 0
    s_getreg_b32 s30, hwreg(HW_REG_XCC_ID, 0, 4)
    s_lshl_b32 s3, s45, 10
    s_waitcnt lgkmcnt(0)
    s_cmp_eq_u32 s33, 0
    s_cselect_b64 exec, -1, 1
    buffer_load_dwordx4 v[112:115], v109, s[24:27], s3 offen
    buffer_load_dwordx4 v[116:119], v109, s[52:55], 0 offen
    s_mov_b64 exec, -1
    s_waitcnt vmcnt(4)
    buffer_load_dwordx4 v[20:23], v1, s[16:19], s35 offen nt
    s_add_u32 s35, s35, 8192
    s_waitcnt vmcnt(4)
    buffer_load_dwordx4 v[24:27], v1, s[16:19], s35 offen nt
    s_add_u32 s35, s35, 8192
    s_waitcnt vmcnt(4)
    buffer_load_dwordx4 v[28:31], v1, s[16:19], s35 offen nt
    s_add_u32 s35, s35, 8192
    s_waitcnt vmcnt(2)
    buffer_load_dwordx4 v[32:35], v1, s[16:19], s35 offen nt
    s_add_u32 s35, s35, 8192
    s_waitcnt vmcnt(2)
    buffer_load_dwordx4 v[36:39], v1, s[16:19], s35 offen nt
    s_mul_i32 s34, s34, 1664525
    s_add_u32 s34, s34, 1013904223
    v_mov_b32 v129, s34
    s_and_b32 s3, s34, -16
    s_or_b32 s30, s30, s3
    v_and_b32 v160, 1, v0
    v_lshlrev_b32 v160, 4, v160
    v_lshrrev_b32 v166, v160, s30
    v_lshrrev_b32 v160, v160, s34
    v_bfe_u32 v167, v166, 8, 8
    v_bfe_u32 v161, v160, 8, 8
    v_and_b32 v166, 0xff, v166
    v_and_b32 v160, 0xff, v160
    s_movk_i32 s11, 0xff
    s_and_b32 s30, s30, 0xffff
    s_mov_b32 s10, 0x0c0c0400
L_tile:
    s_waitcnt vmcnt(6)
    v_perm_b32 v40, v12, v8, s36
    v_perm_b32 v44, v12, v8, s37
    v_perm_b32 v48, v13, v9, s36
    v_perm_b32 v52, v13, v9, s37
    v_perm_b32 v56, v14, v10, s36
    v_perm_b32 v60, v14, v10, s37
    v_perm_b32 v64, v15, v11, s36
    v_perm_b32 v68, v15, v11, s37
    s_waitcnt vmcnt(4)
    v_perm_b32 v41, v20, v16, s36
    v_perm_b32 v45, v20, v16, s37
    v_perm_b32 v49, v21, v17, s36
    v_perm_b32 v53, v21, v17, s37
    v_perm_b32 v57, v22, v18, s36
    v_perm_b32 v61, v22, v18, s37
    v_perm_b32 v65, v23, v19, s36
    v_perm_b32 v69, v23, v19, s37
    s_waitcnt vmcnt(2)
    v_perm_b32 v42, v28, v24, s36
    v_perm_b32 v46, v28, v24, s37
    v_perm_b32 v50, v29, v25, s36
    v_perm_b32 v54, v29, v25, s37
    v_perm_b32 v58, v30, v26, s36
    v_perm_b32 v62, v30, v26, s37
    v_perm_b32 v66, v31, v27, s36
    v_perm_b32 v70, v31, v27, s37
    s_cmp_eq_u32 s41, 0
    s_cbranch_scc0 L_t1
    s_waitcnt vmcnt(0)
    v_perm_b32 v43, v36, v32, s36
    v_perm_b32 v47, v36, v32, s37
    v_perm_b32 v51, v37, v33, s36
    v_perm_b32 v55, v37, v33, s37
    v_perm_b32 v59, v38, v34, s36
    v_perm_b32 v63, v38, v34, s37
    v_perm_b32 v67, v39, v35, s36
    v_perm_b32 v71, v39, v35, s37
    s_branch L_mm
L_t1:
    s_mov_b32 s38, 65536
    s_waitcnt vmcnt(0)
    buffer_load_dwordx2 v[152:153], v1, s[12:15], s39 offen offset:0 sc1
    buffer_load_dwordx2 v[154:155], v1, s[12:15], s39 offen offset:2048 sc1
    buffer_load_dwordx2 v[156:157], v1, s[12:15], s48 offen offset:0 sc1
    buffer_load_dwordx2 v[158:159], v1, s[12:15], s48 offen offset:2048 sc1
    v_perm_b32 v43, v36, v32, s36
    v_perm_b32 v47, v36, v32, s37
    v_perm_b32 v51, v37, v33, s36
    v_perm_b32 v55, v37, v33, s37
    v_perm_b32 v59, v38, v34, s36
    v_perm_b32 v63, v38, v34, s37
    v_perm_b32 v67, v39, v35, s36
    v_perm_b32 v71, v39, v35, s37
    s_branch L_og
L_ogr:
    buffer_load_dwordx2 v[152:153], v1, s[12:15], s39 offen offset:0 sc1
    buffer_load_dwordx2 v[154:155], v1, s[12:15], s39 offen offset:2048 sc1
    buffer_load_dwordx2 v[156:157], v1, s[12:15], s48 offen offset:0 sc1
    buffer_load_dwordx2 v[158:159], v1, s[12:15], s48 offen offset:2048 sc1
L_og:
    s_waitcnt vmcnt(0)
    v_xor_b32 v20, s34, v153
    v_bitop3_b32 v20, v155, s34, v20 bitop3:0xbe
    v_bitop3_b32 v20, v157, s34, v20 bitop3:0xbe
    v_bitop3_b32 v20, v159, s34, v20 bitop3:0xbe
    s_sub_u32 s38, s38, 1
    v_cmp_ne_u32 vcc, 0, v20
    s_cbranch_scc1 L_ogd
    s_cbranch_vccnz L_ogr
L_ogd:
    s_mov_b64 exec, s[6:7]
    buffer_store_dword v129, v135, s[12:15], 0 offen sc1
    s_mov_b64 exec, -1
    v_lshlrev_b32 v24, 16, v152
    v_and_b32 v25, 0xffff0000, v152
    v_lshlrev_b32 v28, 16, v156
    v_and_b32 v29, 0xffff0000, v156
    v_lshlrev_b32 v26, 16, v154
    v_and_b32 v27, 0xffff0000, v154
    v_lshlrev_b32 v30, 16, v158
    v_and_b32 v31, 0xffff0000, v158
    v_pk_mul_f32 v[24:25], v[24:25], v[144:145] op_sel_hi:[1,0]
    v_pk_mul_f32 v[28:29], v[28:29], v[148:149] op_sel_hi:[1,0]
    v_pk_fma_f32 v[24:25], v[26:27], v[146:147], v[24:25] op_sel_hi:[1,0,1]
    v_pk_fma_f32 v[28:29], v[30:31], v[150:151], v[28:29] op_sel_hi:[1,0,1]
    v_pk_add_f32 v[24:25], v[24:25], v[28:29]
    v_cvt_pk_bf16_f32 v104, v24, v25
    s_nop 1
L_mm:
    v_and_b32_dpp v80, v104, v96 quad_perm:[0,0,0,0] row_mask:0xf bank_mask:0xf
    v_and_b32_dpp v81, v104, v96 quad_perm:[1,1,1,1] row_mask:0xf bank_mask:0xf
    v_and_b32_dpp v82, v104, v96 quad_perm:[2,2,2,2] row_mask:0xf bank_mask:0xf
    v_and_b32_dpp v83, v104, v96 quad_perm:[3,3,3,3] row_mask:0xf bank_mask:0xf
    v_and_b32_dpp v84, v104, v97 quad_perm:[0,0,0,0] row_mask:0xf bank_mask:0xf
    v_and_b32_dpp v85, v104, v97 quad_perm:[1,1,1,1] row_mask:0xf bank_mask:0xf
    v_mfma_f32_16x16x32_bf16 v[72:75], v[40:43], v[80:83], 0
    v_and_b32_dpp v86, v104, v97 quad_perm:[2,2,2,2] row_mask:0xf bank_mask:0xf
    v_and_b32_dpp v87, v104, v97 quad_perm:[3,3,3,3] row_mask:0xf bank_mask:0xf
    v_mfma_f32_16x16x32_bf16 v[76:79], v[56:59], v[80:83], 0
    v_and_b32_dpp v88, v104, v98 quad_perm:[0,0,0,0] row_mask:0xf bank_mask:0xf
    v_and_b32_dpp v89, v104, v98 quad_perm:[1,1,1,1] row_mask:0xf bank_mask:0xf
    v_mfma_f32_16x16x32_bf16 v[72:75], v[44:47], v[84:87], v[72:75]
    v_and_b32_dpp v90, v104, v98 quad_perm:[2,2,2,2] row_mask:0xf bank_mask:0xf
    v_and_b32_dpp v91, v104, v98 quad_perm:[3,3,3,3] row_mask:0xf bank_mask:0xf
    v_mfma_f32_16x16x32_bf16 v[76:79], v[60:63], v[84:87], v[76:79]
    v_and_b32_dpp v92, v104, v99 quad_perm:[0,0,0,0] row_mask:0xf bank_mask:0xf
    v_and_b32_dpp v93, v104, v99 quad_perm:[1,1,1,1] row_mask:0xf bank_mask:0xf
    v_mfma_f32_16x16x32_bf16 v[72:75], v[48:51], v[88:91], v[72:75]
    v_and_b32_dpp v94, v104, v99 quad_perm:[2,2,2,2] row_mask:0xf bank_mask:0xf
    v_and_b32_dpp v95, v104, v99 quad_perm:[3,3,3,3] row_mask:0xf bank_mask:0xf
    v_mfma_f32_16x16x32_bf16 v[76:79], v[64:67], v[88:91], v[76:79]
    v_mfma_f32_16x16x32_bf16 v[72:75], v[52:55], v[92:95], v[72:75]
    v_mfma_f32_16x16x32_bf16 v[76:79], v[68:71], v[92:95], v[76:79]
    s_cmp_eq_u32 s41, 0
    s_nop 6
    ds_write_b128 v7, v[72:75]
    ds_write_b128 v7, v[76:79] offset:64
    s_cbranch_scc0 L_fin
    s_mov_b64 exec, 1
    ds_add_u32 v110, v111 offset:1536
    s_mov_b64 exec, -1
    s_mov_b32 s38, 1048576
L_sp_c:
L_spl_c:
    ds_read_b32 v2, v110 offset:1536
    ds_read2_b32 v[12:13], v122 offset0:0 offset1:4
    ds_read2_b32 v[14:15], v123 offset0:0 offset1:4
    ds_read2_b32 v[16:17], v124 offset0:0 offset1:4
    ds_read2_b32 v[18:19], v125 offset0:0 offset1:4
    s_sub_u32 s38, s38, 1
    s_cselect_b32 s3, 0, -1
    s_waitcnt lgkmcnt(0)
    v_readfirstlane_b32 s40, v2
    s_orn2_b32 s40, s40, s3
    s_cmp_lt_u32 s40, 4
    s_cbranch_scc1 L_sp_c
    v_pk_add_f32 v[12:13], v[12:13], v[14:15]
    v_pk_add_f32 v[16:17], v[16:17], v[18:19]
    v_pk_add_f32 v[12:13], v[12:13], v[16:17]
    v_bfi_b32 v164, s11, v166, v12
    v_bfi_b32 v165, s11, v167, v13
    buffer_store_dwordx2 v[164:165], v127, s[12:15], s46 offen
    v_lshlrev_b32 v24, 16, v112
    v_and_b32 v25, 0xffff0000, v112
    v_lshlrev_b32 v32, 16, v116
    v_and_b32 v33, 0xffff0000, v116
    v_lshlrev_b32 v26, 16, v113
    v_and_b32 v27, 0xffff0000, v113
    v_lshlrev_b32 v34, 16, v117
    v_and_b32 v35, 0xffff0000, v117
    v_lshlrev_b32 v28, 16, v114
    v_and_b32 v29, 0xffff0000, v114
    v_lshlrev_b32 v36, 16, v118
    v_and_b32 v37, 0xffff0000, v118
    v_lshlrev_b32 v30, 16, v115
    v_and_b32 v31, 0xffff0000, v115
    v_lshlrev_b32 v38, 16, v119
    v_and_b32 v39, 0xffff0000, v119
    v_pk_mul_f32 v[24:25], v[24:25], v[32:33]
    v_pk_mul_f32 v[26:27], v[26:27], v[34:35]
    v_pk_mul_f32 v[28:29], v[28:29], v[36:37]
    v_pk_mul_f32 v[30:31], v[30:31], v[38:39]
    v_cvt_pk_bf16_f32 v32, v24, v25
    v_cvt_pk_bf16_f32 v33, v26, v27
    v_cvt_pk_bf16_f32 v34, v28, v29
    v_cvt_pk_bf16_f32 v35, v30, v31
    v_lshlrev_b32 v24, 16, v32
    v_and_b32 v25, 0xffff0000, v32
    v_lshlrev_b32 v26, 16, v33
    v_and_b32 v27, 0xffff0000, v33
    v_lshlrev_b32 v28, 16, v34
    v_and_b32 v29, 0xffff0000, v34
    v_lshlrev_b32 v30, 16, v35
    v_and_b32 v31, 0xffff0000, v35
    v_pk_add_f32 v[24:25], v[24:25], v[28:29]
    v_pk_add_f32 v[26:27], v[26:27], v[30:31]
    v_pk_add_f32 v[24:25], v[24:25], v[26:27]
    v_add_f32 v8, v24, v25
    s_nop 1
    v_add_f32_dpp v8, v8, v8 row_ror:8 row_mask:0xf bank_mask:0xf
    s_nop 1
    v_add_f32_dpp v8, v8, v8 row_ror:4 row_mask:0xf bank_mask:0xf
    s_nop 1
    v_add_f32_dpp v8, v8, v8 row_ror:2 row_mask:0xf bank_mask:0xf
    s_nop 1
    v_add_f32_dpp v8, v8, v8 row_ror:1 row_mask:0xf bank_mask:0xf
    v_mov_b32 v9, v8
    s_nop 1
    v_permlane32_swap_b32 v8, v9
    v_add_f32 v8, v8, v9
    v_mov_b32 v9, v8
    s_nop 1
    v_permlane16_swap_b32 v8, v9
    v_add_f32 v8, v8, v9
    v_cvt_pk_bf16_f32 v8, v8, v8
    v_lshlrev_b32 v8, 16, v8
    v_mul_f32 v8, 3216550459, v8
    v_exp_f32 v8, v8
    s_nop 0
    v_add_f32 v8, 1.0, v8
    v_rcp_f32 v8, v8
    s_nop 0
    v_cvt_pk_bf16_f32 v8, v8, v8
    v_lshlrev_b32 v8, 16, v8
    v_sub_f32 v9, 1.0, v8
    v_cvt_pk_bf16_f32 v9, v9, v9
    v_lshlrev_b32 v9, 16, v9
    v_cmp_gt_u32 vcc, 32, v0
    s_lshl_b32 s39, s29, 3
    s_add_u32 s39, s39, s28
    s_lshl_b32 s39, s39, 2
    s_add_u32 s39, s39, s33
    v_cndmask_b32 v120, v9, v8, vcc
    s_lshl_b32 s39, s39, 4
    s_add_u32 s39, s39, s31
    s_lshl_b32 s39, s39, 9
    s_add_u32 s39, s39, 1048576
    s_add_u32 s60, s39, 4096
    s_mov_b32 s63, 0
    v_mov_b32 v18, 0
    v_lshlrev_b32 v19, 11, v6
    s_mov_b32 s38, 8
    s_mov_b32 s62, 65536
    buffer_load_dwordx2 v[40:41], v19, s[12:15], s39 offen sc1
    s_sleep 12
    buffer_load_dwordx2 v[42:43], v19, s[12:15], s39 offen sc1
    s_sleep 12
    buffer_load_dwordx2 v[44:45], v19, s[12:15], s39 offen sc1
    s_sleep 12
L_qf:
    buffer_load_dwordx2 v[46:47], v19, s[12:15], s39 offen sc1
    s_waitcnt vmcnt(3)
    v_perm_b32 v20, v41, v40, s10
    v_cmp_ne_u32 vcc, s30, v20
    s_cmp_eq_u64 vcc, 0
    s_cbranch_scc1 L_qfd
    buffer_load_dwordx2 v[40:41], v19, s[12:15], s39 offen sc1
    s_waitcnt vmcnt(3)
    v_perm_b32 v20, v43, v42, s10
    v_cmp_ne_u32 vcc, s30, v20
    s_cmp_eq_u64 vcc, 0
    s_cbranch_scc1 L_qfd
    buffer_load_dwordx2 v[42:43], v19, s[12:15], s39 offen sc1
    s_waitcnt vmcnt(3)
    v_perm_b32 v20, v45, v44, s10
    v_cmp_ne_u32 vcc, s30, v20
    s_cmp_eq_u64 vcc, 0
    s_cbranch_scc1 L_qfd
    buffer_load_dwordx2 v[44:45], v19, s[12:15], s39 offen sc1
    s_waitcnt vmcnt(3)
    v_perm_b32 v20, v47, v46, s10
    v_cmp_ne_u32 vcc, s30, v20
    s_cmp_eq_u64 vcc, 0
    s_cbranch_scc1 L_qfd
L_qfr:
    s_sub_u32 s38, s38, 1
    s_cbranch_scc0 L_qf
    s_branch L_slow
L_qfd:
    buffer_load_dwordx2 v[24:25], v127, s[12:15], s39 offen offset:0 sc1
    buffer_load_dwordx2 v[26:27], v127, s[12:15], s39 offen offset:2048 sc1
    buffer_load_dwordx2 v[28:29], v127, s[12:15], s60 offen offset:0 sc1
    buffer_load_dwordx2 v[30:31], v127, s[12:15], s60 offen offset:2048 sc1
    s_mul_i32 s3, s33, 272
    v_lshl_add_u32 v16, v0, 2, s3
    v_lshlrev_b32 v1, 11, v4
    v_lshl_add_u32 v1, v3, 4, v1
    s_lshl_b32 s48, s44, 17
    s_lshl_b32 s3, s33, 15
    s_add_u32 s48, s48, s3
    s_lshl_b32 s3, s32, 8
    s_add_u32 s48, s48, s3
    s_waitcnt vmcnt(0) lgkmcnt(0)
    v_xor_b32 v24, v166, v24
    v_xor_b32 v25, v167, v25
    v_xor_b32 v26, v166, v26
    v_xor_b32 v27, v167, v27
    v_xor_b32 v28, v166, v28
    v_xor_b32 v29, v167, v29
    v_xor_b32 v30, v166, v30
    v_xor_b32 v31, v167, v31
    v_or3_b32 v8, v24, v25, v26
    v_or3_b32 v9, v27, v28, v29
    v_or3_b32 v8, v8, v30, v31
    v_bitop3_b32 v8, v8, v9, s11 bitop3:0xa8
    v_cmp_ne_u32 vcc, 0, v8
    s_cmp_eq_u64 vcc, 0
    s_cbranch_scc0 L_qfr
L_qok:
    v_pk_add_f32 v[24:25], v[24:25], v[26:27]
    v_pk_add_f32 v[28:29], v[28:29], v[30:31]
    v_pk_add_f32 v[24:25], v[24:25], v[28:29]
    v_cvt_pk_bf16_f32 v17, v24, v25
    ds_write_b32 v16, v17 offset:0
    s_mov_b64 exec, 1
    ds_add_u32 v110, v18 offset:1548
    ds_add_u32 v110, v111 offset:1540
    s_mov_b64 exec, -1
L_vd:
    ds_read_b32 v2, v110 offset:1540
    ds_read2_b32 v[134:135], v133 offset0:131 offset1:132
    s_waitcnt lgkmcnt(0)
    v_readfirstlane_b32 s40, v2
    v_readfirstlane_b32 s3, v135
    v_readfirstlane_b32 s49, v134
    s_andn2_b32 s3, s3, s63
    s_cbranch_scc1 L_puby2
    s_cmp_ge_u32 s40, 4
    s_cbranch_scc1 L_vdd
    s_sleep 2
    s_sub_u32 s62, s62, 1
    s_cbranch_scc0 L_vd
L_vdd:
    s_lshl_b32 s3, s33, 5
    v_mov_b32 v56, s3
    s_mov_b32 s38, 1048576
    s_branch L_spl_l2
L_sp_l2:
    s_sleep 4
L_spl_l2:
    ds_read_b32 v2, v110 offset:1556
    ds_read_b128 v[40:43], v56 offset:1280
    ds_read_b128 v[44:47], v56 offset:1296
    ds_read_b128 v[48:51], v56 offset:1408
    ds_read_b128 v[52:55], v56 offset:1424
    s_sub_u32 s38, s38, 1
    s_cselect_b32 s3, 0, -1
    s_waitcnt lgkmcnt(0)
    v_readfirstlane_b32 s40, v2
    s_orn2_b32 s40, s40, s3
    s_cmp_lt_u32 s40, 8
    s_cbranch_scc1 L_sp_l2
    v_max3_f32 v40, v40, v41, v42
    v_max3_f32 v43, v43, v44, v45
    v_max3_f32 v40, v40, v46, v47
    v_pk_add_f32 v[48:49], v[48:49], v[52:53]
    v_pk_add_f32 v[50:51], v[50:51], v[54:55]
    v_pk_add_f32 v[48:49], v[48:49], v[50:51]
    v_add_f32 v48, v48, v49
    v_log_f32 v48, v48
    v_max_f32 v40, v40, v43
    s_cmp_lg_u32 s49, 0
    v_add_f32 v128, v40, v48
    s_mov_b64 exec, 1
    s_cbranch_scc1 L_S_y1
    buffer_store_dwordx2 v[128:129], v110, s[12:15], s4 offen
L_S_y1r:
    s_mov_b64 exec, -1
    s_cmp_lg_u32 s49, 0
    s_cselect_b32 s49, 4194304, 0
    s_lshl_b32 s35, s47, 7
    s_add_u32 s35, s35, 786432
    s_add_u32 s35, s35, s49
    v_lshlrev_b32 v57, 5, v5
    s_mov_b32 s38, 65536
    s_branch L_ld_s
L_poll_s:
    s_sleep 8
L_ld_s:
    buffer_load_dwordx4 v[136:139], v57, s[12:15], s35 offen offset:0 sc1
    buffer_load_dwordx4 v[140:143], v57, s[12:15], s35 offen offset:16 sc1
L_chk_s:
    s_waitcnt vmcnt(0)
    v_xor_b32 v20, s34, v137
    v_bitop3_b32 v20, v139, s34, v20 bitop3:0xbe
    v_bitop3_b32 v20, v141, s34, v20 bitop3:0xbe
    v_bitop3_b32 v20, v143, s34, v20 bitop3:0xbe
    s_sub_u32 s38, s38, 1
    v_cmp_ne_u32 vcc, 0, v20
    s_cselect_b64 s[50:51], 0, -1
    s_and_b64 exec, vcc, s[50:51]
    s_cbranch_scc1 L_poll_s
    s_mov_b64 exec, -1
    v_max3_f32 v20, v136, v138, v140
    v_max_f32 v20, v20, v142
    v_sub_f32 v144, v136, v20
    v_sub_f32 v146, v138, v20
    v_sub_f32 v148, v140, v20
    v_sub_f32 v150, v142, v20
    v_exp_f32 v144, v144
    v_exp_f32 v146, v146
    v_exp_f32 v148, v148
    v_exp_f32 v150, v150
    s_nop 0
    v_add_f32 v20, v144, v146
    v_add_f32 v21, v148, v150
    v_add_f32 v20, v20, v21
    v_rcp_f32 v20, v20
    s_nop 0
    v_mul_f32 v144, v144, v20
    v_mul_f32 v146, v146, v20
    v_mul_f32 v148, v148, v20
    v_mul_f32 v150, v150, v20
    s_mov_b32 s38, 1048576
    s_branch L_spl_w
L_sp_w:
    s_sleep 2
L_spl_w:
    ds_read_b32 v2, v110 offset:1560
    s_sub_u32 s38, s38, 1
    s_cselect_b32 s3, 0, -1
    s_waitcnt lgkmcnt(0)
    v_readfirstlane_b32 s40, v2
    s_orn2_b32 s40, s40, s3
    s_cmp_lt_u32 s40, 8
    s_cbranch_scc1 L_sp_w
    s_setprio 0
    buffer_load_dwordx4 v[8:11], v1, s[20:23], s48 offen offset:0 nt
    s_add_u32 s48, s48, 8192
    buffer_load_dwordx4 v[12:15], v1, s[20:23], s48 offen offset:0 nt
    s_add_u32 s48, s48, 8192
    buffer_load_dwordx4 v[16:19], v1, s[20:23], s48 offen offset:0 nt
    s_add_u32 s48, s48, 8192
    buffer_load_dwordx4 v[20:23], v1, s[20:23], s48 offen offset:0 nt
    s_sub_u32 s48, s48, 24576
    buffer_load_dwordx4 v[24:27], v1, s[20:23], s48 offen offset:1024 nt
    s_add_u32 s48, s48, 8192
    buffer_load_dwordx4 v[28:31], v1, s[20:23], s48 offen offset:1024 nt
    s_add_u32 s48, s48, 8192
    buffer_load_dwordx4 v[32:35], v1, s[20:23], s48 offen offset:1024 nt
    s_add_u32 s48, s48, 8192
    buffer_load_dwordx4 v[36:39], v1, s[20:23], s48 offen offset:1024 nt
    s_setprio 3
    s_lshl_b32 s39, s47, 13
    s_lshl_b32 s3, s33, 7
    s_add_u32 s39, s39, s3
    s_add_u32 s39, s39, 1048576
    s_add_u32 s39, s39, s49
    s_add_u32 s48, s39, 4096
    v_lshlrev_b32 v1, 9, v5
    v_lshl_add_u32 v1, v4, 5, v1
    v_lshl_add_u32 v1, v6, 3, v1
    s_lshl_b32 s63, s32, 17
    s_add_u32 s63, s63, 1572864
    s_lshl_b32 s3, s47, 11
    s_add_u32 s46, s63, s3
    s_lshl_b32 s3, s33, 9
    s_add_u32 s46, s46, s3
    v_lshrrev_b32 v121, 2, v0
    v_lshlrev_b32 v121, 11, v121
    v_lshl_add_u32 v121, v6, 3, v121
    s_lshl_b32 s3, s47, 5
    s_add_u32 s63, s63, s3
    s_add_u32 s60, s63, 0x8000
    s_add_u32 s61, s63, 0x10000
    s_add_u32 s62, s63, 0x18000
    s_lshl_b32 s45, s45, 10
    s_lshl_b32 s3, s32, 8
    s_add_u32 s45, s45, s3
    s_and_b32 s3, s47, 15
    s_lshl_b32 s3, s3, 4
    s_add_u32 s45, s45, s3
    v_lshlrev_b32 v126, 2, v6
    v_lshl_add_u32 v126, v4, 1, v126
    s_mov_b32 s41, 1
    s_and_b32 s49, s44, 3
    s_or_b32 s49, s49, s32
    s_or_b32 s49, s49, s33
    s_cselect_b64 s[6:7], 0, 1
    s_lshr_b32 s3, s47, 2
    s_lshl_b32 s3, s3, 10
    s_add_u32 s3, s3, 851968
    v_lshl_add_u32 v135, v0, 7, s3
    v_lshlrev_b32 v134, 10, v3
    v_add_u32 v134, 851968, v134
    s_barrier
    s_branch L_tile
L_fin:
    s_mov_b64 exec, -1
    s_waitcnt lgkmcnt(0)
    s_barrier
    ds_read2_b32 v[12:13], v122 offset0:0 offset1:4
    ds_read2_b32 v[14:15], v123 offset0:0 offset1:4
    ds_read2_b32 v[16:17], v124 offset0:0 offset1:4
    ds_read2_b32 v[18:19], v125 offset0:0 offset1:4
    s_waitcnt lgkmcnt(2)
    v_pk_add_f32 v[12:13], v[12:13], v[14:15]
    s_waitcnt lgkmcnt(0)
    v_pk_add_f32 v[16:17], v[16:17], v[18:19]
    v_pk_add_f32 v[12:13], v[12:13], v[16:17]
    v_bfi_b32 v12, s11, v160, v12
    v_bfi_b32 v13, s11, v161, v13
    buffer_store_dwordx2 v[12:13], v127, s[12:15], s46 offen sc1
    s_cmp_lg_u32 s33, 0
    s_cbranch_scc1 L_C_exit
    s_mov_b32 s38, 65536
L_poll_e:
L_ld_e:
    buffer_load_dword v41, v134, s[12:15], 0 offen sc1
L_chk_e:
    s_waitcnt vmcnt(0)
    v_xor_b32 v40, s34, v41
    s_sub_u32 s38, s38, 1
    v_cmp_ne_u32 vcc, 0, v40
    s_cselect_b64 s[50:51], 0, -1
    s_and_b64 exec, vcc, s[50:51]
    s_cbranch_scc1 L_poll_e
    s_mov_b64 exec, -1
L_eok:
    s_mov_b32 s38, 65536
L_poll_f:
L_ld_f:
    buffer_load_dwordx2 v[24:25], v121, s[12:15], s63 offen sc1
    buffer_load_dwordx2 v[26:27], v121, s[12:15], s60 offen sc1
    buffer_load_dwordx2 v[28:29], v121, s[12:15], s61 offen sc1
    buffer_load_dwordx2 v[30:31], v121, s[12:15], s62 offen sc1
L_chk_f:
    s_waitcnt vmcnt(0)
    v_xor_b32 v24, v160, v24
    v_xor_b32 v25, v161, v25
    v_xor_b32 v26, v160, v26
    v_xor_b32 v27, v161, v27
    v_xor_b32 v28, v160, v28
    v_xor_b32 v29, v161, v29
    v_xor_b32 v30, v160, v30
    v_xor_b32 v31, v161, v31
    v_or3_b32 v40, v24, v25, v26
    v_or3_b32 v41, v27, v28, v29
    v_or3_b32 v40, v40, v30, v31
    v_bitop3_b32 v40, v40, v41, s11 bitop3:0xa8
    s_sub_u32 s38, s38, 1
    v_cmp_ne_u32 vcc, 0, v40
    s_cselect_b64 s[50:51], 0, -1
    s_wqm_b64 vcc, vcc
    s_and_b64 exec, vcc, s[50:51]
    s_cbranch_scc1 L_poll_f
    s_mov_b64 exec, -1
    v_pk_add_f32 v[24:25], v[24:25], v[26:27]
    v_pk_add_f32 v[28:29], v[28:29], v[30:31]
    s_nop 1
    v_permlane32_swap_b32 v24, v28
    v_permlane32_swap_b32 v25, v29
    v_pk_add_f32 v[24:25], v[24:25], v[28:29]
    s_nop 1
    v_permlane16_swap_b32 v24, v25
    v_add_f32 v24, v24, v25
    s_nop 1
    v_add_f32_dpp v24, v24, v24 row_ror:4 row_mask:0xf bank_mask:0xf
    s_nop 1
    v_add_f32_dpp v24, v24, v24 row_ror:8 row_mask:0xf bank_mask:0xf
    v_cvt_pk_bf16_f32 v24, v24, v24
    v_lshlrev_b32 v24, 16, v24
    v_mul_f32 v24, v24, v120
    v_cvt_pk_bf16_f32 v24, v24, v24
    v_lshlrev_b32 v24, 16, v24
    v_mov_b32 v25, v24
    s_nop 1
    v_permlane32_swap_b32 v24, v25
    v_add_f32 v24, v24, v25
    v_cvt_pk_bf16_f32 v24, v24, v24
    s_mov_b64 exec, 0x000f000f
    buffer_store_short v24, v126, s[56:59], s45 offen
    s_cmp_lg_u32 s2, 0
    s_cbranch_scc1 L_C_exit
    s_mov_b64 exec, 1
    buffer_store_dword v129, v110, s[12:15], 0 offen
L_C_exit:
L_end:
    s_endpgm
L_last:
L_S_y1:
    s_add_u32 s4, s4, 4194304
    buffer_store_dwordx2 v[128:129], v110, s[12:15], s4 offen sc1
    s_branch L_S_y1r
L_S_y2:
    s_add_u32 s46, s46, 4194304
    buffer_store_dwordx2 v[164:165], v163, s[12:15], s46 offen sc1
    s_branch L_S_x
L_puby2:
    s_add_u32 s3, s46, 4194304
    buffer_store_dwordx2 v[164:165], v127, s[12:15], s3 offen sc1
    s_mov_b32 s63, 1
    s_branch L_vd
L_slow:
    s_cmp_lg_u32 s63, 0
    s_cbranch_scc1 L_slow2
    ds_write_b32 v110, v111 offset:1552
    s_add_u32 s3, s46, 4194304
    buffer_store_dwordx2 v[164:165], v127, s[12:15], s3 offen sc1
    s_mov_b32 s63, 1
L_slow2:
    v_add_u32 v9, 4194304, v127
    buffer_load_dwordx2 v[24:25], v9, s[12:15], s39 offen offset:0 sc1
    buffer_load_dwordx2 v[26:27], v9, s[12:15], s39 offen offset:2048 sc1
    buffer_load_dwordx2 v[28:29], v9, s[12:15], s60 offen offset:0 sc1
    buffer_load_dwordx2 v[30:31], v9, s[12:15], s60 offen offset:2048 sc1
    v_and_b32 v9, 1, v0
    v_mul_u32_u24 v9, 15, v9
    v_or_b32 v9, 0xf0, v9
    s_waitcnt vmcnt(0)
    v_xor_b32 v8, v166, v24
    v_xor_b32 v10, v167, v25
    v_bitop3_b32 v8, v26, v166, v8 bitop3:0xbe
    v_bitop3_b32 v10, v27, v167, v10 bitop3:0xbe
    v_bitop3_b32 v8, v28, v166, v8 bitop3:0xbe
    v_bitop3_b32 v10, v29, v167, v10 bitop3:0xbe
    v_bitop3_b32 v8, v30, v166, v8 bitop3:0xbe
    v_bitop3_b32 v10, v31, v167, v10 bitop3:0xbe
    v_and_b32 v10, 0xff, v10
    v_and_or_b32 v9, v8, v9, v10
    v_and_b32 v10, 15, v8
    s_mov_b32 s38, 0
    v_cmp_ne_u32 vcc, 0, v9
    s_cmp_eq_u64 vcc, 0
    s_cbranch_scc1 L_slow3
    s_sleep 8
    s_sub_u32 s62, s62, 1
    s_cbranch_scc0 L_qf
L_slow3:
    v_and_b32 v24, 0xffffff00, v24
    v_and_b32 v25, 0xffffff00, v25
    v_and_b32 v26, 0xffffff00, v26
    v_and_b32 v27, 0xffffff00, v27
    v_and_b32 v28, 0xffffff00, v28
    v_and_b32 v29, 0xffffff00, v29
    v_and_b32 v30, 0xffffff00, v30
    v_and_b32 v31, 0xffffff00, v31
    v_cmp_ne_u32 vcc, 0, v10
    s_cmp_lg_u64 vcc, 0
    s_cselect_b32 s3, 1, 0
    v_mov_b32 v18, s3
    s_mul_i32 s3, s33, 272
    v_lshl_add_u32 v16, v0, 2, s3
    v_lshlrev_b32 v1, 11, v4
    v_lshl_add_u32 v1, v3, 4, v1
    s_lshl_b32 s48, s44, 17
    s_lshl_b32 s3, s33, 15
    s_add_u32 s48, s48, s3
    s_lshl_b32 s3, s32, 8
    s_add_u32 s48, s48, s3
    s_waitcnt lgkmcnt(0)
    s_branch L_qok
.section .rodata,"a"
.p2align 6
.amdhsa_kernel gated_mix__sliding_block_cached__sliding_block_cached__decode_kernel
  .amdhsa_next_free_vgpr 168
  .amdhsa_next_free_sgpr 96
  .amdhsa_accum_offset 168
  .amdhsa_group_segment_fixed_size 0
  .amdhsa_kernarg_size 112
  .amdhsa_user_sgpr_count 2
  .amdhsa_user_sgpr_kernarg_segment_ptr 1
  .amdhsa_system_sgpr_workgroup_id_x 1
  .amdhsa_float_denorm_mode_32 3
.end_amdhsa_kernel
```
